```python
import torch

def _softmax(x, axis=-1):
    return torch.softmax(x, dim=axis)
def _gelu(x):
    return torch.nn.functional.gelu(x, approximate="tanh")
def _silu(x):
    return torch.nn.functional.silu(x)
def _sigmoid(x):
    return torch.sigmoid(x)
def _layernorm(x, axis=-1, eps=1e-5):
    m = x.mean(dim=axis, keepdim=True)
    v = x.var(dim=axis, keepdim=True, unbiased=False)
    return (x - m) / torch.sqrt(v + eps)
def _scatter_add(tgt, idx, src, axis=0):
    return tgt.clone().index_add_(axis, idx, src)
def _segment_sum(src, seg, n):
    out = torch.zeros((n,) + src.shape[1:], dtype=src.dtype)
    return out.index_add_(0, seg, src)
def _pad(x, pw):
    flat = tuple(v for pair in reversed(pw) for v in pair)
    return torch.nn.functional.pad(x, flat)

kernel_name = 'standalone__sliding_local_chunked__prompt'

def setup_inputs():

    _w = (lambda a: (lambda t: t.to(torch.bfloat16) if t.is_floating_point() else t)(torch.as_tensor(a)))
    B, H, D = 1, 32, 128
    W = 16
    S = max(W, (2048 // W) * W)
    return {
        "q": _w((lambda *s: torch.randn(*s, dtype=torch.bfloat16) * 0.8)(B, H, S, D)),
        "k": _w((lambda *s: torch.randn(*s, dtype=torch.bfloat16) * 0.8)(B, H, S, D)),
        "v": _w((lambda *s: torch.randn(*s, dtype=torch.bfloat16) * 0.05)(B, H, S, D)),
        "window": W,
    }

def reference(q, k, v, window):
    B, H, S, D = q.shape
    w = window
    nb = S // w
    scale = D ** -0.5
    qb = q.reshape(B, H, nb, w, D)
    kp = _pad(k, ((0, 0), (0, 0), (w, 0), (0, 0)))
    vp = _pad(v, ((0, 0), (0, 0), (w, 0), (0, 0)))
    kpb = kp.reshape(B, H, nb + 1, w, D)
    vpb = vp.reshape(B, H, nb + 1, w, D)
    kb = torch.concatenate([kpb[:, :, :-1], kpb[:, :, 1:]], axis=3)
    vb = torch.concatenate([vpb[:, :, :-1], vpb[:, :, 1:]], axis=3)
    scores = torch.einsum("bhnqd,bhnkd->bhnqk", qb, kb) * scale
    bidx = torch.arange(nb)
    qpos = bidx[:, None] * w + torch.arange(w)[None, :]
    kpos = bidx[:, None] * w + torch.arange(2 * w)[None, :] - w
    diff = qpos[:, :, None] - kpos[:, None, :]
    mask = (diff >= 0) & (diff < w) & (kpos[:, None, :] >= 0)
    scores = torch.where(mask[None, None], scores, -1e9)
    p = _softmax(scores, axis=-1)
    out = torch.einsum("bhnqk,bhnkd->bhnqd", p, vb)
    return out.reshape(B, H, S, D)
```

```asm
; @launch grid=(256,1,1) block=(1024,1,1) lds=139400
.amdgcn_target "amdgcn-amd-amdhsa--gfx950"
.text
.globl standalone__sliding_local_chunked__prompt_kernel
.p2align 8
.type standalone__sliding_local_chunked__prompt_kernel,@function
standalone__sliding_local_chunked__prompt_kernel:
    s_load_dwordx2 s[20:21], s[0:1], 8
    s_load_dwordx2 s[16:17], s[0:1], 0
    s_load_dwordx2 s[24:25], s[0:1], 16
    s_load_dwordx2 s[28:29], s[0:1], 32
    s_cmp_ge_u32 s2, 256
    s_cbranch_scc1 L_exit
    v_lshrrev_b32 v1, 6, v0
    v_and_b32 v0, 63, v0
    v_readfirstlane_b32 s10, v1
    s_lshr_b32 s11, s2, 3
    s_mul_i32 s11, s11, 5
    v_add_u32 v1, s11, v1
    v_and_b32 v1, 15, v1
    s_nop 0
    v_readfirstlane_b32 s3, v1
    v_lshlrev_b32 v38, 3, v1
    v_add_u32 v37, 139272, v38
    v_mov_b32 v42, 0
    v_mov_b32 v43, 0
    s_mov_b64 exec, 1
    ds_write_b64 v37, v[42:43]
    s_mov_b64 exec, -1
    v_max_u32 v38, 8, v38
    v_add_u32 v38, 139264, v38
    v_mov_b32 v39, 1
    s_and_b32 s12, s2, 7
    s_lshr_b32 s13, s2, 3
    s_mul_i32 s12, s12, 32
    s_add_u32 s12, s12, s13
    s_mov_b32 s18, 0x1000000
    s_mov_b32 s19, 0x00020000
    s_mov_b32 s22, 0x1000000
    s_mov_b32 s23, 0x00020000
    s_mov_b32 s26, 0x1000000
    s_mov_b32 s27, 0x00020000
    s_mov_b32 s30, 0x1000000
    s_mov_b32 s31, 0x00020000
    s_getreg_b32 s9, hwreg(HW_REG_XCC_ID, 0, 1)
    s_cmp_eq_u32 s9, 0
    s_cselect_b32 s9, 8, 0
    v_lshrrev_b32 v4, 4, v0
    v_and_b32 v3, 15, v0
    s_mul_i32 s12, s12, 16
    s_lshl_b32 s15, s12, 12
    s_add_u32 s12, s12, s3
    s_mov_b32 s14, s12
    s_lshl_b32 s33, s12, 12
    s_sub_u32 s32, s33, 0x1000
    s_and_b32 s13, s12, 127
    s_cselect_b32 s32, s32, 0x1000000
    s_cselect_b32 s52, 0, 0xf149f2ca
    s_lshl_b32 s34, s3, 13
    v_lshlrev_b32 v6, 2, v4
    v_xor_b32 v6, v6, v3
    v_lshlrev_b32 v6, 4, v6
    v_lshl_add_u32 v32, v4, 8, v6
    v_xor_b32 v33, 16, v32
    v_xor_b32 v34, 32, v32
    v_xor_b32 v35, 48, v32
    v_lshlrev_b32 v40, 4, v0
    v_bfe_u32 v6, v0, 2, 2
    v_lshlrev_b32 v6, 10, v6
    v_and_b32 v7, 3, v0
    v_lshl_add_u32 v6, v4, 6, v6
    v_lshl_add_u32 v1, v7, 4, v6
    s_add_u32 s4, s34, 8192
    s_add_u32 s5, s34, 12288
    s_waitcnt lgkmcnt(0)
    s_cmp_lg_u32 s3, 0
    s_cbranch_scc1 L_nohalo
    s_mov_b32 m0, 0
    s_nop 0
    buffer_load_dwordx4 v32, s[20:23], s32 offen offset:0  lds
    buffer_load_dwordx4 v33, s[20:23], s32 offen offset:1024  lds
    buffer_load_dwordx4 v34, s[20:23], s32 offen offset:2048  lds
    buffer_load_dwordx4 v35, s[20:23], s32 offen offset:3072  lds
L_nohalo:
    s_cmp_eq_u32 s3, 15
    s_cbranch_scc1 L_last
    buffer_load_dwordx4 v[44:47], v1, s[16:19], s33 offen offset:0 nt
    buffer_load_dwordx4 v[48:51], v1, s[16:19], s33 offen offset:256 nt
    buffer_load_dwordx4 v[52:55], v1, s[16:19], s33 offen offset:512 nt
    buffer_load_dwordx4 v[56:59], v1, s[16:19], s33 offen offset:768 nt
    s_barrier
    s_mov_b32 m0, s4
    s_nop 0
    buffer_load_dwordx4 v32, s[20:23], s33 offen offset:0 nt lds
    buffer_load_dwordx4 v33, s[20:23], s33 offen offset:1024 nt lds
    buffer_load_dwordx4 v34, s[20:23], s33 offen offset:2048 nt lds
    buffer_load_dwordx4 v35, s[20:23], s33 offen offset:3072 nt lds
    s_barrier
    s_cmp_lg_u32 s3, 0
    s_cbranch_scc1 L_hv101
    s_mov_b32 m0, 4096
    s_nop 0
    buffer_load_dwordx4 v40, s[24:27], s32 offen offset:0  lds
    buffer_load_dwordx4 v40, s[24:27], s32 offen offset:1024  lds
    buffer_load_dwordx4 v40, s[24:27], s32 offen offset:2048  lds
    buffer_load_dwordx4 v40, s[24:27], s32 offen offset:3072  lds
L_hv101:
    s_mov_b32 m0, s5
    s_nop 0
    buffer_load_dwordx4 v40, s[24:27], s33 offen offset:0 nt lds
    buffer_load_dwordx4 v40, s[24:27], s33 offen offset:1024 nt lds
    buffer_load_dwordx4 v40, s[24:27], s33 offen offset:2048 nt lds
    buffer_load_dwordx4 v40, s[24:27], s33 offen offset:3072 nt lds
    s_branch L_issued
L_last:
    buffer_load_dwordx4 v[44:47], v1, s[16:19], s33 offen offset:0 nt
    buffer_load_dwordx4 v[48:51], v1, s[16:19], s33 offen offset:256 nt
    buffer_load_dwordx4 v[52:55], v1, s[16:19], s33 offen offset:512 nt
    buffer_load_dwordx4 v[56:59], v1, s[16:19], s33 offen offset:768 nt
    s_barrier
    s_mov_b32 m0, s4
    s_nop 0
    buffer_load_dwordx4 v32, s[20:23], s33 offen offset:0  lds
    buffer_load_dwordx4 v33, s[20:23], s33 offen offset:1024  lds
    buffer_load_dwordx4 v34, s[20:23], s33 offen offset:2048  lds
    buffer_load_dwordx4 v35, s[20:23], s33 offen offset:3072  lds
    s_barrier
    s_cmp_lg_u32 s3, 0
    s_cbranch_scc1 L_hv130
    s_mov_b32 m0, 4096
    s_nop 0
    buffer_load_dwordx4 v40, s[24:27], s32 offen offset:0  lds
    buffer_load_dwordx4 v40, s[24:27], s32 offen offset:1024  lds
    buffer_load_dwordx4 v40, s[24:27], s32 offen offset:2048  lds
    buffer_load_dwordx4 v40, s[24:27], s32 offen offset:3072  lds
L_hv130:
    s_mov_b32 m0, s5
    s_nop 0
    buffer_load_dwordx4 v40, s[24:27], s33 offen offset:0  lds
    buffer_load_dwordx4 v40, s[24:27], s33 offen offset:1024  lds
    buffer_load_dwordx4 v40, s[24:27], s33 offen offset:2048  lds
    buffer_load_dwordx4 v40, s[24:27], s33 offen offset:3072  lds
L_issued:
    v_lshlrev_b32 v2, 10, v4
    v_lshl_add_u32 v2, v3, 4, v2
    v_add_u32 v36, s34, v2
    v_and_b32 v6, 3, v3
    v_xor_b32 v6, v6, v4
    v_lshrrev_b32 v7, 2, v3
    v_lshl_add_u32 v6, v6, 2, v7
    v_lshlrev_b32 v6, 4, v6
    v_lshl_add_u32 v6, v3, 8, v6
    v_add_u32 v28, s34, v6
    v_xor_b32 v29, 16, v28
    v_xor_b32 v30, 32, v28
    v_xor_b32 v31, 48, v28
    s_mov_b32 s40, 0xfff0ffff
    s_mov_b32 s41, 0xf000ff00
    s_mov_b32 s42, 0xffe0fffe
    s_mov_b32 s43, 0xe000fe00
    s_mov_b32 s44, 0xffc0fffc
    s_mov_b32 s45, 0xc000fc00
    s_mov_b32 s46, 0xff80fff8
    s_mov_b32 s47, 0x8000f800
    s_mov_b32 s54, 0x55555555
    s_mov_b32 s55, s54
    s_mov_b32 s56, 0xaaaaaaaa
    s_mov_b32 s57, s56
    s_mov_b32 s58, 0x33333333
    s_mov_b32 s59, s58
    s_mov_b32 s60, 0xcccccccc
    s_mov_b32 s61, s60
    s_mov_b32 s48, 0x05040100
    s_mov_b32 s49, 0x07060302
    s_mov_b32 s50, 0x3db504f3
    s_mov_b32 s51, 0x3fb8aa3b
    s_mov_b32 s53, 0xffff0000
    v_mov_b32 v10, 0xffff
    v_mov_b32 v11, 0xffff0000
    v_cndmask_b32 v6, 0, v10, s[40:41]
    v_cndmask_b32 v7, 0, v11, s[42:43]
    v_cndmask_b32 v8, 0, v10, s[44:45]
    v_cndmask_b32 v9, 0, v11, s[46:47]
    v_or_b32 v3, v6, v7
    v_or_b32 v4, v8, v9
    v_mov_b32 v24, s52
    v_mov_b32 v25, s52
    v_mov_b32 v26, s52
    v_mov_b32 v27, s52
    s_cmp_ge_u32 s10, s9
    s_cbranch_scc1 L_bbl
    s_waitcnt vmcnt(0)
L_bbl:
    s_barrier
    s_waitcnt vmcnt(8)
    s_mov_b64 vcc, s[54:55]
    v_cndmask_b32_dpp v92, v48, v44, vcc quad_perm:[1,0,3,2] row_mask:0xf bank_mask:0xf
    v_cndmask_b32_dpp v93, v49, v45, vcc quad_perm:[1,0,3,2] row_mask:0xf bank_mask:0xf
    v_cndmask_b32_dpp v94, v50, v46, vcc quad_perm:[1,0,3,2] row_mask:0xf bank_mask:0xf
    v_cndmask_b32_dpp v95, v51, v47, vcc quad_perm:[1,0,3,2] row_mask:0xf bank_mask:0xf
    v_cndmask_b32_dpp v100, v56, v52, vcc quad_perm:[1,0,3,2] row_mask:0xf bank_mask:0xf
    v_cndmask_b32_dpp v101, v57, v53, vcc quad_perm:[1,0,3,2] row_mask:0xf bank_mask:0xf
    v_cndmask_b32_dpp v102, v58, v54, vcc quad_perm:[1,0,3,2] row_mask:0xf bank_mask:0xf
    v_cndmask_b32_dpp v103, v59, v55, vcc quad_perm:[1,0,3,2] row_mask:0xf bank_mask:0xf
    s_mov_b64 vcc, s[56:57]
    v_cndmask_b32_dpp v96, v44, v48, vcc quad_perm:[1,0,3,2] row_mask:0xf bank_mask:0xf
    v_cndmask_b32_dpp v97, v45, v49, vcc quad_perm:[1,0,3,2] row_mask:0xf bank_mask:0xf
    v_cndmask_b32_dpp v98, v46, v50, vcc quad_perm:[1,0,3,2] row_mask:0xf bank_mask:0xf
    v_cndmask_b32_dpp v99, v47, v51, vcc quad_perm:[1,0,3,2] row_mask:0xf bank_mask:0xf
    v_cndmask_b32_dpp v104, v52, v56, vcc quad_perm:[1,0,3,2] row_mask:0xf bank_mask:0xf
    v_cndmask_b32_dpp v105, v53, v57, vcc quad_perm:[1,0,3,2] row_mask:0xf bank_mask:0xf
    v_cndmask_b32_dpp v106, v54, v58, vcc quad_perm:[1,0,3,2] row_mask:0xf bank_mask:0xf
    v_cndmask_b32_dpp v107, v55, v59, vcc quad_perm:[1,0,3,2] row_mask:0xf bank_mask:0xf
    s_mov_b64 vcc, s[58:59]
    v_cndmask_b32_dpp v44, v100, v92, vcc quad_perm:[2,3,0,1] row_mask:0xf bank_mask:0xf
    v_cndmask_b32_dpp v45, v101, v93, vcc quad_perm:[2,3,0,1] row_mask:0xf bank_mask:0xf
    v_cndmask_b32_dpp v46, v102, v94, vcc quad_perm:[2,3,0,1] row_mask:0xf bank_mask:0xf
    v_cndmask_b32_dpp v47, v103, v95, vcc quad_perm:[2,3,0,1] row_mask:0xf bank_mask:0xf
    v_cndmask_b32_dpp v48, v104, v96, vcc quad_perm:[2,3,0,1] row_mask:0xf bank_mask:0xf
    v_cndmask_b32_dpp v49, v105, v97, vcc quad_perm:[2,3,0,1] row_mask:0xf bank_mask:0xf
    v_cndmask_b32_dpp v50, v106, v98, vcc quad_perm:[2,3,0,1] row_mask:0xf bank_mask:0xf
    v_cndmask_b32_dpp v51, v107, v99, vcc quad_perm:[2,3,0,1] row_mask:0xf bank_mask:0xf
    s_mov_b64 vcc, s[60:61]
    v_cndmask_b32_dpp v52, v92, v100, vcc quad_perm:[2,3,0,1] row_mask:0xf bank_mask:0xf
    v_cndmask_b32_dpp v53, v93, v101, vcc quad_perm:[2,3,0,1] row_mask:0xf bank_mask:0xf
    v_cndmask_b32_dpp v54, v94, v102, vcc quad_perm:[2,3,0,1] row_mask:0xf bank_mask:0xf
    v_cndmask_b32_dpp v55, v95, v103, vcc quad_perm:[2,3,0,1] row_mask:0xf bank_mask:0xf
    v_cndmask_b32_dpp v56, v96, v104, vcc quad_perm:[2,3,0,1] row_mask:0xf bank_mask:0xf
    v_cndmask_b32_dpp v57, v97, v105, vcc quad_perm:[2,3,0,1] row_mask:0xf bank_mask:0xf
    v_cndmask_b32_dpp v58, v98, v106, vcc quad_perm:[2,3,0,1] row_mask:0xf bank_mask:0xf
    v_cndmask_b32_dpp v59, v99, v107, vcc quad_perm:[2,3,0,1] row_mask:0xf bank_mask:0xf
    s_waitcnt vmcnt(4)
    s_mov_b64 exec, 1
    ds_write_b32 v37, v39 offset:0
    s_mov_b64 exec, -1
    ds_read_b32 v5, v38
    ds_read_b128 v[60:63], v28
    ds_read_b128 v[64:67], v29
    ds_read_b128 v[68:71], v30
    ds_read_b128 v[72:75], v31
    ds_read_b128 v[76:79], v28 offset:8192
    ds_read_b128 v[80:83], v29 offset:8192
    ds_read_b128 v[84:87], v30 offset:8192
    ds_read_b128 v[88:91], v31 offset:8192
    s_waitcnt lgkmcnt(0)
    v_readfirstlane_b32 s35, v5
    s_cmp_eq_u32 s35, 1
    s_cbranch_scc0 L_kspin
L_kok:
    v_mfma_f32_16x16x32_bf16 v[20:23], v[76:79], v[44:47], 0
    v_mfma_f32_16x16x32_bf16 v[16:19], v[60:63], v[44:47], v[24:27]
    v_mfma_f32_16x16x32_bf16 v[20:23], v[80:83], v[48:51], v[20:23]
    v_mfma_f32_16x16x32_bf16 v[16:19], v[64:67], v[48:51], v[16:19]
    v_mfma_f32_16x16x32_bf16 v[20:23], v[84:87], v[52:55], v[20:23]
    v_mfma_f32_16x16x32_bf16 v[16:19], v[68:71], v[52:55], v[16:19]
    v_mfma_f32_16x16x32_bf16 v[20:23], v[88:91], v[56:59], v[20:23]
    v_mfma_f32_16x16x32_bf16 v[16:19], v[72:75], v[56:59], v[16:19]
    s_nop 7
    v_cndmask_b32 v6, v16, v20, s[40:41]
    v_cndmask_b32 v7, v17, v21, s[42:43]
    v_cndmask_b32 v8, v18, v22, s[44:45]
    v_cndmask_b32 v9, v19, v23, s[46:47]
    v_cvt_pk_bf16_f32 v10, v6, v7
    v_cvt_pk_bf16_f32 v11, v8, v9
    v_lshlrev_b32 v6, 16, v10
    v_and_b32 v7, s53, v10
    v_lshlrev_b32 v8, 16, v11
    v_and_b32 v9, s53, v11
    v_mul_f32 v6, s50, v6
    v_mul_f32 v7, s50, v7
    v_mul_f32 v8, s50, v8
    v_mul_f32 v9, s50, v9
    v_cvt_pk_bf16_f32 v10, v6, v7
    v_cvt_pk_bf16_f32 v11, v8, v9
    v_lshlrev_b32 v6, 16, v10
    v_and_b32 v7, s53, v10
    v_lshlrev_b32 v8, 16, v11
    v_and_b32 v9, s53, v11
    v_max3_f32 v10, v6, v7, v8
    v_max_f32 v10, v10, v9
    v_mov_b32 v11, v10
    s_nop 1
    v_permlane16_swap_b32 v10, v11
    s_nop 1
    v_max_f32 v10, v10, v11
    v_mov_b32 v11, v10
    s_nop 1
    v_permlane32_swap_b32 v10, v11
    s_nop 1
    v_max_f32 v10, v10, v11
    v_sub_f32 v6, v6, v10
    v_sub_f32 v7, v7, v10
    v_sub_f32 v8, v8, v10
    v_sub_f32 v9, v9, v10
    v_mul_f32 v6, s51, v6
    v_mul_f32 v7, s51, v7
    v_mul_f32 v8, s51, v8
    v_mul_f32 v9, s51, v9
    v_exp_f32 v6, v6
    v_exp_f32 v7, v7
    v_exp_f32 v8, v8
    v_exp_f32 v9, v9
    s_nop 0
    v_add_f32 v10, v6, v7
    v_add_f32 v11, v8, v9
    v_add_f32 v10, v10, v11
    v_mov_b32 v11, v10
    s_nop 1
    v_permlane16_swap_b32 v10, v11
    s_nop 1
    v_add_f32 v10, v10, v11
    v_mov_b32 v11, v10
    s_nop 1
    v_permlane32_swap_b32 v10, v11
    s_nop 1
    v_add_f32 v10, v10, v11
    v_rcp_f32 v10, v10
    s_nop 0
    v_mul_f32 v6, v6, v10
    v_mul_f32 v7, v7, v10
    v_mul_f32 v8, v8, v10
    v_mul_f32 v9, v9, v10
    v_cvt_pk_bf16_f32 v10, v6, v7
    v_cvt_pk_bf16_f32 v11, v8, v9
    v_and_b32 v14, v3, v10
    v_and_b32 v15, v4, v11
    v_xor_b32 v12, v14, v10
    v_xor_b32 v13, v15, v11
    s_waitcnt vmcnt(0)
    s_mov_b64 exec, 1
    ds_write_b32 v37, v39 offset:4
    s_mov_b64 exec, -1
    ds_read_b128 v[108:111], v36 offset:12288
    ds_read_b128 v[112:115], v36 offset:12544
    ds_read_b128 v[116:119], v36 offset:12800
    ds_read_b128 v[120:123], v36 offset:13056
    ds_read_b32 v5, v38 offset:4
    ds_read_b128 v[92:95], v36 offset:4096
    ds_read_b128 v[96:99], v36 offset:4352
    ds_read_b128 v[100:103], v36 offset:4608
    ds_read_b128 v[104:107], v36 offset:4864
    s_waitcnt lgkmcnt(5)
    v_perm_b32 v62, v112, v108, s48
    v_perm_b32 v63, v120, v116, s48
    v_perm_b32 v66, v112, v108, s49
    v_perm_b32 v67, v120, v116, s49
    v_perm_b32 v70, v113, v109, s48
    v_perm_b32 v71, v121, v117, s48
    v_perm_b32 v74, v113, v109, s49
    v_perm_b32 v75, v121, v117, s49
    v_perm_b32 v78, v114, v110, s48
    v_perm_b32 v79, v122, v118, s48
    v_perm_b32 v82, v114, v110, s49
    v_perm_b32 v83, v122, v118, s49
    v_perm_b32 v86, v115, v111, s48
    v_perm_b32 v87, v123, v119, s48
    v_perm_b32 v90, v115, v111, s49
    v_perm_b32 v91, v123, v119, s49
    s_waitcnt lgkmcnt(0)
    v_readfirstlane_b32 s35, v5
    s_cmp_eq_u32 s35, 1
    s_cbranch_scc0 L_vspin
L_vok:
    v_perm_b32 v60, v96, v92, s48
    v_perm_b32 v61, v104, v100, s48
    v_perm_b32 v64, v96, v92, s49
    v_perm_b32 v65, v104, v100, s49
    v_perm_b32 v68, v97, v93, s48
    v_perm_b32 v69, v105, v101, s48
    v_perm_b32 v72, v97, v93, s49
    v_perm_b32 v73, v105, v101, s49
    v_perm_b32 v76, v98, v94, s48
    v_perm_b32 v77, v106, v102, s48
    v_perm_b32 v80, v98, v94, s49
    v_perm_b32 v81, v106, v102, s49
    v_perm_b32 v84, v99, v95, s48
    v_perm_b32 v85, v107, v103, s48
    v_perm_b32 v88, v99, v95, s49
    v_perm_b32 v89, v107, v103, s49
    s_nop 1
    v_mfma_f32_16x16x32_bf16 v[92:95], v[12:15], v[60:63], 0
    v_mfma_f32_16x16x32_bf16 v[96:99], v[12:15], v[64:67], 0
    v_mfma_f32_16x16x32_bf16 v[100:103], v[12:15], v[68:71], 0
    v_mfma_f32_16x16x32_bf16 v[104:107], v[12:15], v[72:75], 0
    v_mfma_f32_16x16x32_bf16 v[108:111], v[12:15], v[76:79], 0
    v_mfma_f32_16x16x32_bf16 v[112:115], v[12:15], v[80:83], 0
    v_mfma_f32_16x16x32_bf16 v[116:119], v[12:15], v[84:87], 0
    v_mfma_f32_16x16x32_bf16 v[120:123], v[12:15], v[88:91], 0
    s_nop 7
    v_cvt_pk_bf16_f32 v44, v92, v96
    v_cvt_pk_bf16_f32 v45, v100, v104
    v_cvt_pk_bf16_f32 v46, v108, v112
    v_cvt_pk_bf16_f32 v47, v116, v120
    buffer_store_dwordx4 v[44:47], v2, s[28:31], s33 offen offset:0 nt
    v_cvt_pk_bf16_f32 v48, v93, v97
    v_cvt_pk_bf16_f32 v49, v101, v105
    v_cvt_pk_bf16_f32 v50, v109, v113
    v_cvt_pk_bf16_f32 v51, v117, v121
    buffer_store_dwordx4 v[48:51], v2, s[28:31], s33 offen offset:256 nt
    v_cvt_pk_bf16_f32 v52, v94, v98
    v_cvt_pk_bf16_f32 v53, v102, v106
    v_cvt_pk_bf16_f32 v54, v110, v114
    v_cvt_pk_bf16_f32 v55, v118, v122
    buffer_store_dwordx4 v[52:55], v2, s[28:31], s33 offen offset:512 nt
    v_cvt_pk_bf16_f32 v56, v95, v99
    v_cvt_pk_bf16_f32 v57, v103, v107
    v_cvt_pk_bf16_f32 v58, v111, v115
    v_cvt_pk_bf16_f32 v59, v119, v123
    buffer_store_dwordx4 v[56:59], v2, s[28:31], s33 offen offset:768 nt
L_end:
L_exit:
    s_endpgm
L_kspin:
    ds_read_b32 v5, v38 offset:0
    s_waitcnt lgkmcnt(0)
    v_readfirstlane_b32 s35, v5
    s_cmp_eq_u32 s35, 1
    s_cbranch_scc0 L_kspin
    ds_read_b128 v[60:63], v28
    ds_read_b128 v[64:67], v29
    ds_read_b128 v[68:71], v30
    ds_read_b128 v[72:75], v31
    s_waitcnt lgkmcnt(0)
    s_branch L_kok
L_vspin:
    ds_read_b32 v5, v38 offset:4
    s_waitcnt lgkmcnt(0)
    v_readfirstlane_b32 s35, v5
    s_cmp_eq_u32 s35, 1
    s_cbranch_scc0 L_vspin
    ds_read_b128 v[92:95], v36 offset:4096
    ds_read_b128 v[96:99], v36 offset:4352
    ds_read_b128 v[100:103], v36 offset:4608
    ds_read_b128 v[104:107], v36 offset:4864
    s_waitcnt lgkmcnt(0)
    s_branch L_vok
.section .rodata,"a"
.p2align 6
.amdhsa_kernel standalone__sliding_local_chunked__prompt_kernel
  .amdhsa_next_free_vgpr 124
  .amdhsa_next_free_sgpr 64
  .amdhsa_accum_offset 124
  .amdhsa_group_segment_fixed_size 0
  .amdhsa_kernarg_size 56
  .amdhsa_user_sgpr_count 2
  .amdhsa_user_sgpr_kernarg_segment_ptr 1
  .amdhsa_system_sgpr_workgroup_id_x 1
  .amdhsa_float_denorm_mode_32 3
.end_amdhsa_kernel
```
